```python
import torch

def _softmax(x, axis=-1):
    return torch.softmax(x, dim=axis)
def _gelu(x):
    return torch.nn.functional.gelu(x, approximate="tanh")
def _silu(x):
    return torch.nn.functional.silu(x)
def _sigmoid(x):
    return torch.sigmoid(x)
def _layernorm(x, axis=-1, eps=1e-5):
    m = x.mean(dim=axis, keepdim=True)
    v = x.var(dim=axis, keepdim=True, unbiased=False)
    return (x - m) / torch.sqrt(v + eps)
def _scatter_add(tgt, idx, src, axis=0):
    return tgt.clone().index_add_(axis, idx, src)
def _segment_sum(src, seg, n):
    out = torch.zeros((n,) + src.shape[1:], dtype=src.dtype)
    return out.index_add_(0, seg, src)
def _pad(x, pw):
    flat = tuple(v for pair in reversed(pw) for v in pair)
    return torch.nn.functional.pad(x, flat)

kernel_name = 'standalone__linear_kernel_rfa__decode'

def setup_inputs():

    _w = (lambda a: (lambda t: t.to(torch.bfloat16) if t.is_floating_point() else t)(torch.as_tensor(a)))
    B, H, Sq, Sk, D, M = 2, 32, 1, 4096, 128, 8
    return {
        "q": _w((lambda *s: torch.randn(*s, dtype=torch.bfloat16) * 0.4)(B, H, Sq, D)),
        "k": _w((lambda *s: torch.randn(*s, dtype=torch.bfloat16) * 1.6)(B, H, Sk, D)),
        "v": _w((lambda *s: torch.randn(*s, dtype=torch.bfloat16) * 1.6)(B, H, Sk, D)),
        "omega": _w((lambda *s: torch.randn(*s, dtype=torch.bfloat16) * 1.6)(M, D)),
    }

def reference(q, k, v, omega):
    d = q.shape[-1]
    m = omega.shape[0]
    scale = float(d) ** -0.25
    qs = q * scale
    ks = k * scale
    q_proj = torch.einsum("bhsd,md->bhsm", qs, omega)
    k_proj = torch.einsum("bhsd,md->bhsm", ks, omega)
    q_sq = 0.5 * torch.einsum("bhsd,bhsd->bhs", qs, qs)[..., None]
    k_sq = 0.5 * torch.einsum("bhsd,bhsd->bhs", ks, ks)[..., None]
    inv_sqrt_m = float(m) ** -0.5
    phi_q = torch.exp(q_proj - q_sq) * inv_sqrt_m + 1e-6
    phi_k = torch.exp(k_proj - k_sq) * inv_sqrt_m + 1e-6
    kv = torch.einsum("bhsm,bhsd->bhmd", phi_k, v)
    z  = torch.einsum("bhsm->bhm", phi_k)
    num = torch.einsum("bhqm,bhmd->bhqd", phi_q, kv)
    den = torch.einsum("bhqm,bhm->bhq", phi_q, z)[..., None] + 1e-6
    return num / den
```

```asm
; @launch grid=(256,1,1) block=(512,1,1) lds=65536
.amdgcn_target "amdgcn-amd-amdhsa--gfx950"
.text
.globl standalone__linear_kernel_rfa__decode_kernel
.p2align 8
.type standalone__linear_kernel_rfa__decode_kernel,@function
standalone__linear_kernel_rfa__decode_kernel:
    s_cmp_ge_u32 s2, 256
    s_cbranch_scc1 L_end
    s_load_dwordx8 s[4:11], s[0:1], 0
    s_load_dwordx4 s[12:15], s[0:1], 32
    s_load_dwordx2 s[16:17], s[0:1], 48
    v_lshrrev_b32 v25, 6, v0
    v_and_b32 v3, 63, v0
    v_readfirstlane_b32 s56, v25
    s_and_b32 s3, s2, 3
    s_lshr_b32 s57, s2, 3
    s_lshl_b32 s57, s57, 2
    s_add_u32 s3, s3, s57
    s_and_b32 s57, s2, 4
    s_lshl_b32 s57, s57, 5
    s_add_u32 s3, s3, s57
    v_and_b32 v80, 15, v3
    v_lshrrev_b32 v85, 4, v3
    v_lshlrev_b32 v86, 2, v85
    v_xor_b32 v86, v86, v80
    v_lshlrev_b32 v86, 4, v86
    v_lshl_add_u32 v86, v85, 8, v86
    s_lshl_b32 s45, s56, 13
    s_add_u32 s19, s45, 4096
    v_add_u32 v116, s45, v86
    v_xor_b32 v117, 16, v116
    v_xor_b32 v118, 32, v116
    v_xor_b32 v119, 48, v116
    v_lshlrev_b32 v2, 4, v3
    v_add_u32 v2, s45, v2
    s_mov_b32 s44, 4096
    s_lshl_b32 s57, s3, 18
    s_mov_b32 s22, 262144
    s_mov_b32 s23, 0x00020000
    s_mov_b32 s26, 262144
    s_mov_b32 s27, 0x00020000
    s_mov_b32 s30, 2048
    s_mov_b32 s31, 0x00020000
    v_lshlrev_b32 v81, 4, v85
    v_lshl_add_u32 v84, v80, 8, v81
    s_lshr_b32 s54, s3, 2
    s_and_b32 s55, s3, 3
    s_waitcnt lgkmcnt(0)
    s_add_u32 s20, s6, s57
    s_addc_u32 s21, s7, 0
    s_mov_b32 m0, s45
    s_nop 0
    buffer_load_dwordx4 v116, s[20:23], 0 offen offset:0 nt lds
    buffer_load_dwordx4 v117, s[20:23], 0 offen offset:1024 nt lds
    buffer_load_dwordx4 v118, s[20:23], 0 offen offset:2048 nt lds
    buffer_load_dwordx4 v119, s[20:23], 0 offen offset:3072 nt lds
    s_mov_b32 m0, s19
    s_nop 0
    buffer_load_dwordx4 v116, s[20:23], s44 offen offset:0 nt lds
    buffer_load_dwordx4 v117, s[20:23], s44 offen offset:1024 nt lds
    buffer_load_dwordx4 v118, s[20:23], s44 offen offset:2048 nt lds
    buffer_load_dwordx4 v119, s[20:23], s44 offen offset:3072 nt lds
    v_add_u32 v116, 65536, v116
    v_add_u32 v117, 65536, v117
    v_add_u32 v118, 65536, v118
    v_add_u32 v119, 65536, v119
    s_mov_b32 s28, s10
    s_mov_b32 s29, s11
    s_add_u32 s24, s8, s57
    s_addc_u32 s25, s9, 0
    buffer_load_dwordx4 v[4:7], v84, s[28:31], 0 offen offset:0
    buffer_load_dwordx4 v[8:11], v84, s[28:31], 0 offen offset:64
    buffer_load_dwordx4 v[12:15], v84, s[28:31], 0 offen offset:128
    buffer_load_dwordx4 v[16:19], v84, s[28:31], 0 offen offset:192
    buffer_load_dwordx4 v[156:159], v2, s[24:27], 0 offen offset:0 nt
    buffer_load_dwordx4 v[160:163], v2, s[24:27], 0 offen offset:1024 nt
    buffer_load_dwordx4 v[164:167], v2, s[24:27], 0 offen offset:2048 nt
    buffer_load_dwordx4 v[168:171], v2, s[24:27], 0 offen offset:3072 nt
    buffer_load_dwordx4 v[172:175], v2, s[24:27], s44 offen offset:0 nt
    buffer_load_dwordx4 v[176:179], v2, s[24:27], s44 offen offset:1024 nt
    buffer_load_dwordx4 v[180:183], v2, s[24:27], s44 offen offset:2048 nt
    buffer_load_dwordx4 v[184:187], v2, s[24:27], s44 offen offset:3072 nt
    v_add_u32 v2, 65536, v2
    s_lshl_b32 s57, s54, 8
    s_add_u32 s32, s4, s57
    s_addc_u32 s33, s5, 0
    s_mov_b32 s34, 256
    s_mov_b32 s35, 0x00020000
    v_and_b32 v82, 3, v80
    v_lshrrev_b32 v83, 2, v80
    v_lshl_add_u32 v82, v82, 2, v83
    v_xor_b32 v83, v85, v80
    v_lshlrev_b32 v83, 4, v83
    v_lshl_add_u32 v83, v82, 8, v83
    v_add_u32 v120, s45, v83
    v_xor_b32 v121, 64, v120
    v_xor_b32 v122, 128, v120
    v_xor_b32 v123, 192, v120
    s_mov_b32 s40, s14
    s_mov_b32 s41, s15
    s_mov_b32 s42, 256
    s_mov_b32 s43, 0x00020000
    s_mov_b32 s46, 0x3e9837f0
    s_mov_b32 s47, 0x3e9837f0
    s_mov_b32 s48, 0x3fb8aa3b
    s_mov_b32 s49, 0x3eb504f3
    s_mov_b32 s50, 0x358637bd
    s_mov_b32 s51, 0x05040100
    s_mov_b32 s52, 0x07060302
    v_mov_b32 v20, 0x3f803f80
    v_mov_b32 v21, 0x3f803f80
    v_mov_b32 v22, 0x3f803f80
    v_mov_b32 v23, 0x3f803f80
    v_mov_b32 v24, 1.0
    v_mov_b32 v28, 0
    v_mov_b32 v29, 0
    v_mov_b32 v30, 0
    v_mov_b32 v31, 0
    v_mov_b32 v32, 0
    v_mov_b32 v33, 0
    v_mov_b32 v34, 0
    v_mov_b32 v35, 0
    v_mov_b32 v36, 0
    v_mov_b32 v37, 0
    v_mov_b32 v38, 0
    v_mov_b32 v39, 0
    v_mov_b32 v40, 0
    v_mov_b32 v41, 0
    v_mov_b32 v42, 0
    v_mov_b32 v43, 0
    v_mov_b32 v44, 0
    v_mov_b32 v45, 0
    v_mov_b32 v46, 0
    v_mov_b32 v47, 0
    v_mov_b32 v48, 0
    v_mov_b32 v49, 0
    v_mov_b32 v50, 0
    v_mov_b32 v51, 0
    v_mov_b32 v52, 0
    v_mov_b32 v53, 0
    v_mov_b32 v54, 0
    v_mov_b32 v55, 0
    v_mov_b32 v56, 0
    v_mov_b32 v57, 0
    v_mov_b32 v58, 0
    v_mov_b32 v59, 0
    v_mov_b32 v60, 0
    v_mov_b32 v61, 0
    v_mov_b32 v62, 0
    v_mov_b32 v63, 0
    s_mov_b32 s53, 4
    s_cmp_lg_u32 s56, 0
    s_cbranch_scc1 L_loop
    buffer_load_dwordx4 v[192:195], v81, s[32:35], 0 offen offset:0
    buffer_load_dwordx4 v[196:199], v81, s[32:35], 0 offen offset:64
    buffer_load_dwordx4 v[200:203], v81, s[32:35], 0 offen offset:128
    buffer_load_dwordx4 v[204:207], v81, s[32:35], 0 offen offset:192
L_loop:
    s_waitcnt vmcnt(8)
    ds_read_b128 v[124:127], v120 offset:0
    ds_read_b128 v[128:131], v121 offset:0
    ds_read_b128 v[132:135], v122 offset:0
    ds_read_b128 v[136:139], v123 offset:0
    ds_read_b128 v[140:143], v120 offset:4096
    ds_read_b128 v[144:147], v121 offset:4096
    ds_read_b128 v[148:151], v122 offset:4096
    ds_read_b128 v[152:155], v123 offset:4096
    s_waitcnt lgkmcnt(0)
    s_cmp_eq_u32 s53, 1
    s_cbranch_scc1 L_nok
    s_mov_b32 m0, s45
    s_nop 0
    buffer_load_dwordx4 v116, s[20:23], 0 offen offset:0 nt lds
    buffer_load_dwordx4 v117, s[20:23], 0 offen offset:1024 nt lds
    buffer_load_dwordx4 v118, s[20:23], 0 offen offset:2048 nt lds
    buffer_load_dwordx4 v119, s[20:23], 0 offen offset:3072 nt lds
    s_mov_b32 m0, s19
    s_nop 0
    buffer_load_dwordx4 v116, s[20:23], s44 offen offset:0 nt lds
    buffer_load_dwordx4 v117, s[20:23], s44 offen offset:1024 nt lds
    buffer_load_dwordx4 v118, s[20:23], s44 offen offset:2048 nt lds
    buffer_load_dwordx4 v119, s[20:23], s44 offen offset:3072 nt lds
    v_add_u32 v116, 65536, v116
    v_add_u32 v117, 65536, v117
    v_add_u32 v118, 65536, v118
    v_add_u32 v119, 65536, v119
    s_nop 4
L_nok:
    v_lshlrev_b32 v80, 16, v124
    v_and_b32 v81, 0xffff0000, v124
    v_lshlrev_b32 v82, 16, v125
    v_and_b32 v83, 0xffff0000, v125
    v_lshlrev_b32 v84, 16, v126
    v_and_b32 v85, 0xffff0000, v126
    v_lshlrev_b32 v86, 16, v127
    v_and_b32 v87, 0xffff0000, v127
    v_pk_mul_f32 v[80:81], v[80:81], s[46:47]
    v_pk_mul_f32 v[82:83], v[82:83], s[46:47]
    v_pk_mul_f32 v[84:85], v[84:85], s[46:47]
    v_pk_mul_f32 v[86:87], v[86:87], s[46:47]
    v_cvt_pk_bf16_f32 v124, v80, v81
    v_cvt_pk_bf16_f32 v125, v82, v83
    v_cvt_pk_bf16_f32 v126, v84, v85
    v_cvt_pk_bf16_f32 v127, v86, v87
    v_dot2_f32_bf16 v112, v124, v124, 0
    v_dot2_f32_bf16 v113, v125, v125, 0
    v_dot2_f32_bf16 v112, v126, v126, v112
    v_dot2_f32_bf16 v113, v127, v127, v113
    v_lshlrev_b32 v88, 16, v128
    v_and_b32 v89, 0xffff0000, v128
    v_lshlrev_b32 v90, 16, v129
    v_and_b32 v91, 0xffff0000, v129
    v_lshlrev_b32 v92, 16, v130
    v_and_b32 v93, 0xffff0000, v130
    v_lshlrev_b32 v94, 16, v131
    v_and_b32 v95, 0xffff0000, v131
    v_pk_mul_f32 v[88:89], v[88:89], s[46:47]
    v_pk_mul_f32 v[90:91], v[90:91], s[46:47]
    v_pk_mul_f32 v[92:93], v[92:93], s[46:47]
    v_pk_mul_f32 v[94:95], v[94:95], s[46:47]
    v_cvt_pk_bf16_f32 v128, v88, v89
    v_cvt_pk_bf16_f32 v129, v90, v91
    v_cvt_pk_bf16_f32 v130, v92, v93
    v_cvt_pk_bf16_f32 v131, v94, v95
    v_dot2_f32_bf16 v112, v128, v128, v112
    v_dot2_f32_bf16 v113, v129, v129, v113
    v_dot2_f32_bf16 v112, v130, v130, v112
    v_dot2_f32_bf16 v113, v131, v131, v113
    v_lshlrev_b32 v80, 16, v132
    v_and_b32 v81, 0xffff0000, v132
    v_lshlrev_b32 v82, 16, v133
    v_and_b32 v83, 0xffff0000, v133
    v_lshlrev_b32 v84, 16, v134
    v_and_b32 v85, 0xffff0000, v134
    v_lshlrev_b32 v86, 16, v135
    v_and_b32 v87, 0xffff0000, v135
    v_pk_mul_f32 v[80:81], v[80:81], s[46:47]
    v_pk_mul_f32 v[82:83], v[82:83], s[46:47]
    v_pk_mul_f32 v[84:85], v[84:85], s[46:47]
    v_pk_mul_f32 v[86:87], v[86:87], s[46:47]
    v_cvt_pk_bf16_f32 v132, v80, v81
    v_cvt_pk_bf16_f32 v133, v82, v83
    v_cvt_pk_bf16_f32 v134, v84, v85
    v_cvt_pk_bf16_f32 v135, v86, v87
    v_dot2_f32_bf16 v112, v132, v132, v112
    v_dot2_f32_bf16 v113, v133, v133, v113
    v_dot2_f32_bf16 v112, v134, v134, v112
    v_dot2_f32_bf16 v113, v135, v135, v113
    v_lshlrev_b32 v88, 16, v136
    v_and_b32 v89, 0xffff0000, v136
    v_lshlrev_b32 v90, 16, v137
    v_and_b32 v91, 0xffff0000, v137
    v_lshlrev_b32 v92, 16, v138
    v_and_b32 v93, 0xffff0000, v138
    v_lshlrev_b32 v94, 16, v139
    v_and_b32 v95, 0xffff0000, v139
    v_pk_mul_f32 v[88:89], v[88:89], s[46:47]
    v_pk_mul_f32 v[90:91], v[90:91], s[46:47]
    v_pk_mul_f32 v[92:93], v[92:93], s[46:47]
    v_pk_mul_f32 v[94:95], v[94:95], s[46:47]
    v_cvt_pk_bf16_f32 v136, v88, v89
    v_cvt_pk_bf16_f32 v137, v90, v91
    v_cvt_pk_bf16_f32 v138, v92, v93
    v_cvt_pk_bf16_f32 v139, v94, v95
    v_dot2_f32_bf16 v112, v136, v136, v112
    v_dot2_f32_bf16 v113, v137, v137, v113
    v_dot2_f32_bf16 v112, v138, v138, v112
    v_dot2_f32_bf16 v113, v139, v139, v113
    v_mfma_f32_16x16x32_bf16 v[64:67], v[124:127], v[4:7], 0
    v_mfma_f32_16x16x32_bf16 v[64:67], v[128:131], v[8:11], v[64:67]
    v_mfma_f32_16x16x32_bf16 v[64:67], v[132:135], v[12:15], v[64:67]
    v_mfma_f32_16x16x32_bf16 v[64:67], v[136:139], v[16:19], v[64:67]
    v_add_f32 v112, v112, v113
    s_nop 1
    v_mfma_f32_16x16x4_f32 v[68:71], v112, v24, 0
    v_lshlrev_b32 v80, 16, v140
    v_and_b32 v81, 0xffff0000, v140
    v_lshlrev_b32 v82, 16, v141
    v_and_b32 v83, 0xffff0000, v141
    v_lshlrev_b32 v84, 16, v142
    v_and_b32 v85, 0xffff0000, v142
    v_lshlrev_b32 v86, 16, v143
    v_and_b32 v87, 0xffff0000, v143
    v_pk_mul_f32 v[80:81], v[80:81], s[46:47]
    v_pk_mul_f32 v[82:83], v[82:83], s[46:47]
    v_pk_mul_f32 v[84:85], v[84:85], s[46:47]
    v_pk_mul_f32 v[86:87], v[86:87], s[46:47]
    v_cvt_pk_bf16_f32 v140, v80, v81
    v_cvt_pk_bf16_f32 v141, v82, v83
    v_cvt_pk_bf16_f32 v142, v84, v85
    v_cvt_pk_bf16_f32 v143, v86, v87
    v_dot2_f32_bf16 v114, v140, v140, 0
    v_dot2_f32_bf16 v115, v141, v141, 0
    v_dot2_f32_bf16 v114, v142, v142, v114
    v_dot2_f32_bf16 v115, v143, v143, v115
    v_lshlrev_b32 v88, 16, v144
    v_and_b32 v89, 0xffff0000, v144
    v_lshlrev_b32 v90, 16, v145
    v_and_b32 v91, 0xffff0000, v145
    v_lshlrev_b32 v92, 16, v146
    v_and_b32 v93, 0xffff0000, v146
    v_lshlrev_b32 v94, 16, v147
    v_and_b32 v95, 0xffff0000, v147
    v_pk_mul_f32 v[88:89], v[88:89], s[46:47]
    v_pk_mul_f32 v[90:91], v[90:91], s[46:47]
    v_pk_mul_f32 v[92:93], v[92:93], s[46:47]
    v_pk_mul_f32 v[94:95], v[94:95], s[46:47]
    v_cvt_pk_bf16_f32 v144, v88, v89
    v_cvt_pk_bf16_f32 v145, v90, v91
    v_cvt_pk_bf16_f32 v146, v92, v93
    v_cvt_pk_bf16_f32 v147, v94, v95
    v_dot2_f32_bf16 v114, v144, v144, v114
    v_dot2_f32_bf16 v115, v145, v145, v115
    v_dot2_f32_bf16 v114, v146, v146, v114
    v_dot2_f32_bf16 v115, v147, v147, v115
    v_lshlrev_b32 v80, 16, v148
    v_and_b32 v81, 0xffff0000, v148
    v_lshlrev_b32 v82, 16, v149
    v_and_b32 v83, 0xffff0000, v149
    v_lshlrev_b32 v84, 16, v150
    v_and_b32 v85, 0xffff0000, v150
    v_lshlrev_b32 v86, 16, v151
    v_and_b32 v87, 0xffff0000, v151
    v_pk_mul_f32 v[80:81], v[80:81], s[46:47]
    v_pk_mul_f32 v[82:83], v[82:83], s[46:47]
    v_pk_mul_f32 v[84:85], v[84:85], s[46:47]
    v_pk_mul_f32 v[86:87], v[86:87], s[46:47]
    v_cvt_pk_bf16_f32 v148, v80, v81
    v_cvt_pk_bf16_f32 v149, v82, v83
    v_cvt_pk_bf16_f32 v150, v84, v85
    v_cvt_pk_bf16_f32 v151, v86, v87
    v_dot2_f32_bf16 v114, v148, v148, v114
    v_dot2_f32_bf16 v115, v149, v149, v115
    v_dot2_f32_bf16 v114, v150, v150, v114
    v_dot2_f32_bf16 v115, v151, v151, v115
    v_lshlrev_b32 v88, 16, v152
    v_and_b32 v89, 0xffff0000, v152
    v_lshlrev_b32 v90, 16, v153
    v_and_b32 v91, 0xffff0000, v153
    v_lshlrev_b32 v92, 16, v154
    v_and_b32 v93, 0xffff0000, v154
    v_lshlrev_b32 v94, 16, v155
    v_and_b32 v95, 0xffff0000, v155
    v_pk_mul_f32 v[88:89], v[88:89], s[46:47]
    v_pk_mul_f32 v[90:91], v[90:91], s[46:47]
    v_pk_mul_f32 v[92:93], v[92:93], s[46:47]
    v_pk_mul_f32 v[94:95], v[94:95], s[46:47]
    v_cvt_pk_bf16_f32 v152, v88, v89
    v_cvt_pk_bf16_f32 v153, v90, v91
    v_cvt_pk_bf16_f32 v154, v92, v93
    v_cvt_pk_bf16_f32 v155, v94, v95
    v_dot2_f32_bf16 v114, v152, v152, v114
    v_dot2_f32_bf16 v115, v153, v153, v115
    v_dot2_f32_bf16 v114, v154, v154, v114
    v_dot2_f32_bf16 v115, v155, v155, v115
    v_mfma_f32_16x16x32_bf16 v[72:75], v[140:143], v[4:7], 0
    v_mfma_f32_16x16x32_bf16 v[72:75], v[144:147], v[8:11], v[72:75]
    v_mfma_f32_16x16x32_bf16 v[72:75], v[148:151], v[12:15], v[72:75]
    v_mfma_f32_16x16x32_bf16 v[72:75], v[152:155], v[16:19], v[72:75]
    v_add_f32 v114, v114, v115
    s_nop 1
    v_mfma_f32_16x16x4_f32 v[76:79], v114, v24, 0
    v_cvt_pk_bf16_f32 v80, v64, v65
    v_cvt_pk_bf16_f32 v81, v66, v67
    v_lshlrev_b32 v64, 16, v80
    v_and_b32 v65, 0xffff0000, v80
    v_lshlrev_b32 v66, 16, v81
    v_and_b32 v67, 0xffff0000, v81
    v_cvt_pk_bf16_f32 v82, v68, v69
    v_cvt_pk_bf16_f32 v83, v70, v71
    v_lshlrev_b32 v68, 16, v82
    v_and_b32 v69, 0xffff0000, v82
    v_lshlrev_b32 v70, 16, v83
    v_and_b32 v71, 0xffff0000, v83
    v_cvt_pk_bf16_f32 v84, v72, v73
    v_cvt_pk_bf16_f32 v85, v74, v75
    v_lshlrev_b32 v72, 16, v84
    v_and_b32 v73, 0xffff0000, v84
    v_lshlrev_b32 v74, 16, v85
    v_and_b32 v75, 0xffff0000, v85
    v_cvt_pk_bf16_f32 v86, v76, v77
    v_cvt_pk_bf16_f32 v87, v78, v79
    v_lshlrev_b32 v76, 16, v86
    v_and_b32 v77, 0xffff0000, v86
    v_lshlrev_b32 v78, 16, v87
    v_and_b32 v79, 0xffff0000, v87
    v_fma_f32 v64, v68, -0.5, v64
    v_fma_f32 v65, v69, -0.5, v65
    v_fma_f32 v66, v70, -0.5, v66
    v_fma_f32 v67, v71, -0.5, v67
    v_fma_f32 v72, v76, -0.5, v72
    v_fma_f32 v73, v77, -0.5, v73
    v_fma_f32 v74, v78, -0.5, v74
    v_fma_f32 v75, v79, -0.5, v75
    v_cvt_pk_bf16_f32 v80, v64, v65
    v_cvt_pk_bf16_f32 v81, v66, v67
    v_lshlrev_b32 v64, 16, v80
    v_and_b32 v65, 0xffff0000, v80
    v_lshlrev_b32 v66, 16, v81
    v_and_b32 v67, 0xffff0000, v81
    v_cvt_pk_bf16_f32 v84, v72, v73
    v_cvt_pk_bf16_f32 v85, v74, v75
    v_lshlrev_b32 v72, 16, v84
    v_and_b32 v73, 0xffff0000, v84
    v_lshlrev_b32 v74, 16, v85
    v_and_b32 v75, 0xffff0000, v85
    v_mul_f32 v64, s48, v64
    v_mul_f32 v65, s48, v65
    v_mul_f32 v66, s48, v66
    v_mul_f32 v67, s48, v67
    v_mul_f32 v72, s48, v72
    v_mul_f32 v73, s48, v73
    v_mul_f32 v74, s48, v74
    v_mul_f32 v75, s48, v75
    v_exp_f32 v64, v64
    v_exp_f32 v65, v65
    v_exp_f32 v66, v66
    v_exp_f32 v67, v67
    v_exp_f32 v72, v72
    v_exp_f32 v73, v73
    v_exp_f32 v74, v74
    v_exp_f32 v75, v75
    v_cvt_pk_bf16_f32 v80, v64, v65
    v_cvt_pk_bf16_f32 v81, v66, v67
    v_lshlrev_b32 v64, 16, v80
    v_and_b32 v65, 0xffff0000, v80
    v_lshlrev_b32 v66, 16, v81
    v_and_b32 v67, 0xffff0000, v81
    v_cvt_pk_bf16_f32 v84, v72, v73
    v_cvt_pk_bf16_f32 v85, v74, v75
    v_lshlrev_b32 v72, 16, v84
    v_and_b32 v73, 0xffff0000, v84
    v_lshlrev_b32 v74, 16, v85
    v_and_b32 v75, 0xffff0000, v85
    v_mul_f32 v64, s49, v64
    v_mul_f32 v65, s49, v65
    v_mul_f32 v66, s49, v66
    v_mul_f32 v67, s49, v67
    v_mul_f32 v72, s49, v72
    v_mul_f32 v73, s49, v73
    v_mul_f32 v74, s49, v74
    v_mul_f32 v75, s49, v75
    v_cvt_pk_bf16_f32 v80, v64, v65
    v_cvt_pk_bf16_f32 v81, v66, v67
    v_lshlrev_b32 v64, 16, v80
    v_and_b32 v65, 0xffff0000, v80
    v_lshlrev_b32 v66, 16, v81
    v_and_b32 v67, 0xffff0000, v81
    v_cvt_pk_bf16_f32 v84, v72, v73
    v_cvt_pk_bf16_f32 v85, v74, v75
    v_lshlrev_b32 v72, 16, v84
    v_and_b32 v73, 0xffff0000, v84
    v_lshlrev_b32 v74, 16, v85
    v_and_b32 v75, 0xffff0000, v85
    v_add_f32 v64, s50, v64
    v_add_f32 v65, s50, v65
    v_add_f32 v66, s50, v66
    v_add_f32 v67, s50, v67
    v_add_f32 v72, s50, v72
    v_add_f32 v73, s50, v73
    v_add_f32 v74, s50, v74
    v_add_f32 v75, s50, v75
    v_cvt_pk_bf16_f32 v96, v64, v65
    v_cvt_pk_bf16_f32 v97, v66, v67
    v_cvt_pk_bf16_f32 v98, v72, v73
    v_cvt_pk_bf16_f32 v99, v74, v75
    s_cmp_lg_u32 s53, 1
    s_cbranch_scc1 L_w8
    s_waitcnt vmcnt(0)
    s_nop 1
L_w8:
    s_waitcnt vmcnt(8)
    v_perm_b32 v100, v160, v156, s51
    v_perm_b32 v101, v168, v164, s51
    v_perm_b32 v102, v176, v172, s51
    v_perm_b32 v103, v184, v180, s51
    s_nop 1
    v_mfma_f32_16x16x32_bf16 v[28:31], v[96:99], v[100:103], v[28:31]
    v_perm_b32 v104, v160, v156, s52
    v_perm_b32 v105, v168, v164, s52
    v_perm_b32 v106, v176, v172, s52
    v_perm_b32 v107, v184, v180, s52
    s_nop 1
    v_mfma_f32_16x16x32_bf16 v[32:35], v[96:99], v[104:107], v[32:35]
    v_perm_b32 v108, v161, v157, s51
    v_perm_b32 v109, v169, v165, s51
    v_perm_b32 v110, v177, v173, s51
    v_perm_b32 v111, v185, v181, s51
    s_nop 1
    v_mfma_f32_16x16x32_bf16 v[36:39], v[96:99], v[108:111], v[36:39]
    v_perm_b32 v100, v161, v157, s52
    v_perm_b32 v101, v169, v165, s52
    v_perm_b32 v102, v177, v173, s52
    v_perm_b32 v103, v185, v181, s52
    s_nop 1
    v_mfma_f32_16x16x32_bf16 v[40:43], v[96:99], v[100:103], v[40:43]
    v_perm_b32 v104, v162, v158, s51
    v_perm_b32 v105, v170, v166, s51
    v_perm_b32 v106, v178, v174, s51
    v_perm_b32 v107, v186, v182, s51
    s_nop 1
    v_mfma_f32_16x16x32_bf16 v[44:47], v[96:99], v[104:107], v[44:47]
    v_perm_b32 v108, v162, v158, s52
    v_perm_b32 v109, v170, v166, s52
    v_perm_b32 v110, v178, v174, s52
    v_perm_b32 v111, v186, v182, s52
    s_nop 1
    v_mfma_f32_16x16x32_bf16 v[48:51], v[96:99], v[108:111], v[48:51]
    v_perm_b32 v100, v163, v159, s51
    v_perm_b32 v101, v171, v167, s51
    v_perm_b32 v102, v179, v175, s51
    v_perm_b32 v103, v187, v183, s51
    s_nop 1
    v_mfma_f32_16x16x32_bf16 v[52:55], v[96:99], v[100:103], v[52:55]
    v_perm_b32 v104, v163, v159, s52
    v_perm_b32 v105, v171, v167, s52
    v_perm_b32 v106, v179, v175, s52
    v_perm_b32 v107, v187, v183, s52
    s_nop 1
    v_mfma_f32_16x16x32_bf16 v[56:59], v[96:99], v[104:107], v[56:59]
    v_mfma_f32_16x16x32_bf16 v[60:63], v[96:99], v[20:23], v[60:63]
    s_sub_u32 s53, s53, 1
    s_cmp_eq_u32 s53, 0
    s_cbranch_scc1 L_done
    buffer_load_dwordx4 v[156:159], v2, s[24:27], 0 offen offset:0 nt
    buffer_load_dwordx4 v[160:163], v2, s[24:27], 0 offen offset:1024 nt
    buffer_load_dwordx4 v[164:167], v2, s[24:27], 0 offen offset:2048 nt
    buffer_load_dwordx4 v[168:171], v2, s[24:27], 0 offen offset:3072 nt
    buffer_load_dwordx4 v[172:175], v2, s[24:27], s44 offen offset:0 nt
    buffer_load_dwordx4 v[176:179], v2, s[24:27], s44 offen offset:1024 nt
    buffer_load_dwordx4 v[180:183], v2, s[24:27], s44 offen offset:2048 nt
    buffer_load_dwordx4 v[184:187], v2, s[24:27], s44 offen offset:3072 nt
    v_add_u32 v2, 65536, v2
    s_cmp_lg_u32 s53, 3
    s_cbranch_scc1 L_loop
    s_cmp_lg_u32 s56, 0
    s_cbranch_scc1 L_loop
    v_lshlrev_b32 v80, 16, v192
    v_and_b32 v81, 0xffff0000, v192
    v_lshlrev_b32 v82, 16, v193
    v_and_b32 v83, 0xffff0000, v193
    v_lshlrev_b32 v84, 16, v194
    v_and_b32 v85, 0xffff0000, v194
    v_lshlrev_b32 v86, 16, v195
    v_and_b32 v87, 0xffff0000, v195
    v_pk_mul_f32 v[80:81], v[80:81], s[46:47]
    v_pk_mul_f32 v[82:83], v[82:83], s[46:47]
    v_pk_mul_f32 v[84:85], v[84:85], s[46:47]
    v_pk_mul_f32 v[86:87], v[86:87], s[46:47]
    v_cvt_pk_bf16_f32 v192, v80, v81
    v_cvt_pk_bf16_f32 v193, v82, v83
    v_cvt_pk_bf16_f32 v194, v84, v85
    v_cvt_pk_bf16_f32 v195, v86, v87
    v_dot2_f32_bf16 v112, v192, v192, 0
    v_dot2_f32_bf16 v113, v193, v193, 0
    v_dot2_f32_bf16 v112, v194, v194, v112
    v_dot2_f32_bf16 v113, v195, v195, v113
    v_lshlrev_b32 v88, 16, v196
    v_and_b32 v89, 0xffff0000, v196
    v_lshlrev_b32 v90, 16, v197
    v_and_b32 v91, 0xffff0000, v197
    v_lshlrev_b32 v92, 16, v198
    v_and_b32 v93, 0xffff0000, v198
    v_lshlrev_b32 v94, 16, v199
    v_and_b32 v95, 0xffff0000, v199
    v_pk_mul_f32 v[88:89], v[88:89], s[46:47]
    v_pk_mul_f32 v[90:91], v[90:91], s[46:47]
    v_pk_mul_f32 v[92:93], v[92:93], s[46:47]
    v_pk_mul_f32 v[94:95], v[94:95], s[46:47]
    v_cvt_pk_bf16_f32 v196, v88, v89
    v_cvt_pk_bf16_f32 v197, v90, v91
    v_cvt_pk_bf16_f32 v198, v92, v93
    v_cvt_pk_bf16_f32 v199, v94, v95
    v_dot2_f32_bf16 v112, v196, v196, v112
    v_dot2_f32_bf16 v113, v197, v197, v113
    v_dot2_f32_bf16 v112, v198, v198, v112
    v_dot2_f32_bf16 v113, v199, v199, v113
    v_lshlrev_b32 v80, 16, v200
    v_and_b32 v81, 0xffff0000, v200
    v_lshlrev_b32 v82, 16, v201
    v_and_b32 v83, 0xffff0000, v201
    v_lshlrev_b32 v84, 16, v202
    v_and_b32 v85, 0xffff0000, v202
    v_lshlrev_b32 v86, 16, v203
    v_and_b32 v87, 0xffff0000, v203
    v_pk_mul_f32 v[80:81], v[80:81], s[46:47]
    v_pk_mul_f32 v[82:83], v[82:83], s[46:47]
    v_pk_mul_f32 v[84:85], v[84:85], s[46:47]
    v_pk_mul_f32 v[86:87], v[86:87], s[46:47]
    v_cvt_pk_bf16_f32 v200, v80, v81
    v_cvt_pk_bf16_f32 v201, v82, v83
    v_cvt_pk_bf16_f32 v202, v84, v85
    v_cvt_pk_bf16_f32 v203, v86, v87
    v_dot2_f32_bf16 v112, v200, v200, v112
    v_dot2_f32_bf16 v113, v201, v201, v113
    v_dot2_f32_bf16 v112, v202, v202, v112
    v_dot2_f32_bf16 v113, v203, v203, v113
    v_lshlrev_b32 v88, 16, v204
    v_and_b32 v89, 0xffff0000, v204
    v_lshlrev_b32 v90, 16, v205
    v_and_b32 v91, 0xffff0000, v205
    v_lshlrev_b32 v92, 16, v206
    v_and_b32 v93, 0xffff0000, v206
    v_lshlrev_b32 v94, 16, v207
    v_and_b32 v95, 0xffff0000, v207
    v_pk_mul_f32 v[88:89], v[88:89], s[46:47]
    v_pk_mul_f32 v[90:91], v[90:91], s[46:47]
    v_pk_mul_f32 v[92:93], v[92:93], s[46:47]
    v_pk_mul_f32 v[94:95], v[94:95], s[46:47]
    v_cvt_pk_bf16_f32 v204, v88, v89
    v_cvt_pk_bf16_f32 v205, v90, v91
    v_cvt_pk_bf16_f32 v206, v92, v93
    v_cvt_pk_bf16_f32 v207, v94, v95
    v_dot2_f32_bf16 v112, v204, v204, v112
    v_dot2_f32_bf16 v113, v205, v205, v113
    v_dot2_f32_bf16 v112, v206, v206, v112
    v_dot2_f32_bf16 v113, v207, v207, v113
    v_mfma_f32_16x16x32_bf16 v[64:67], v[192:195], v[4:7], 0
    v_mfma_f32_16x16x32_bf16 v[64:67], v[196:199], v[8:11], v[64:67]
    v_mfma_f32_16x16x32_bf16 v[64:67], v[200:203], v[12:15], v[64:67]
    v_mfma_f32_16x16x32_bf16 v[64:67], v[204:207], v[16:19], v[64:67]
    v_add_f32 v112, v112, v113
    s_nop 1
    v_mfma_f32_16x16x4_f32 v[68:71], v112, v24, 0
    s_nop 3
    v_cvt_pk_bf16_f32 v80, v64, v65
    v_cvt_pk_bf16_f32 v81, v66, v67
    v_lshlrev_b32 v64, 16, v80
    v_and_b32 v65, 0xffff0000, v80
    v_lshlrev_b32 v66, 16, v81
    v_and_b32 v67, 0xffff0000, v81
    v_cvt_pk_bf16_f32 v82, v68, v69
    v_cvt_pk_bf16_f32 v83, v70, v71
    v_lshlrev_b32 v68, 16, v82
    v_and_b32 v69, 0xffff0000, v82
    v_lshlrev_b32 v70, 16, v83
    v_and_b32 v71, 0xffff0000, v83
    v_fma_f32 v64, v68, -0.5, v64
    v_fma_f32 v65, v69, -0.5, v65
    v_fma_f32 v66, v70, -0.5, v66
    v_fma_f32 v67, v71, -0.5, v67
    v_cvt_pk_bf16_f32 v80, v64, v65
    v_cvt_pk_bf16_f32 v81, v66, v67
    v_lshlrev_b32 v64, 16, v80
    v_and_b32 v65, 0xffff0000, v80
    v_lshlrev_b32 v66, 16, v81
    v_and_b32 v67, 0xffff0000, v81
    v_mul_f32 v64, s48, v64
    v_mul_f32 v65, s48, v65
    v_mul_f32 v66, s48, v66
    v_mul_f32 v67, s48, v67
    v_exp_f32 v64, v64
    v_exp_f32 v65, v65
    v_exp_f32 v66, v66
    v_exp_f32 v67, v67
    v_cvt_pk_bf16_f32 v80, v64, v65
    v_cvt_pk_bf16_f32 v81, v66, v67
    v_lshlrev_b32 v64, 16, v80
    v_and_b32 v65, 0xffff0000, v80
    v_lshlrev_b32 v66, 16, v81
    v_and_b32 v67, 0xffff0000, v81
    v_mul_f32 v64, s49, v64
    v_mul_f32 v65, s49, v65
    v_mul_f32 v66, s49, v66
    v_mul_f32 v67, s49, v67
    v_cvt_pk_bf16_f32 v80, v64, v65
    v_cvt_pk_bf16_f32 v81, v66, v67
    v_lshlrev_b32 v64, 16, v80
    v_and_b32 v65, 0xffff0000, v80
    v_lshlrev_b32 v66, 16, v81
    v_and_b32 v67, 0xffff0000, v81
    v_add_f32 v64, s50, v64
    v_add_f32 v65, s50, v65
    v_add_f32 v66, s50, v66
    v_add_f32 v67, s50, v67
    v_cvt_pk_bf16_f32 v96, v64, v65
    v_cvt_pk_bf16_f32 v97, v66, v67
    v_lshlrev_b32 v80, 16, v96
    s_nop 0
    v_readlane_b32 s60, v80, 0
    v_readlane_b32 s61, v80, 1
    v_readlane_b32 s62, v80, 2
    v_readlane_b32 s63, v80, 3
    v_readlane_b32 s64, v80, 4
    v_readlane_b32 s65, v80, 5
    v_readlane_b32 s66, v80, 6
    v_readlane_b32 s67, v80, 7
    s_lshr_b32 s60, s60, 16
    s_or_b32 s60, s60, s61
    s_lshr_b32 s62, s62, 16
    s_or_b32 s62, s62, s63
    s_lshr_b32 s64, s64, 16
    s_or_b32 s64, s64, s65
    s_lshr_b32 s66, s66, 16
    s_or_b32 s66, s66, s67
    s_branch L_loop
L_done:
    s_mul_i32 s57, s54, 18432
    s_add_u32 s32, s16, s57
    s_addc_u32 s33, s17, 0
    s_mov_b32 s34, 18432
    s_mov_b32 s35, 0x00020000
    v_lshlrev_b32 v25, 4, v3
    v_add_u32 v25, s45, v25
    s_mov_b32 exec_hi, 0
    ds_write_b128 v25, v[28:31] offset:0
    ds_write_b128 v25, v[32:35] offset:512
    ds_write_b128 v25, v[36:39] offset:1024
    ds_write_b128 v25, v[40:43] offset:1536
    ds_write_b128 v25, v[44:47] offset:2048
    ds_write_b128 v25, v[48:51] offset:2560
    ds_write_b128 v25, v[52:55] offset:3072
    ds_write_b128 v25, v[56:59] offset:3584
    ds_write_b128 v25, v[60:63] offset:4096
    s_mov_b64 exec, -1
    s_waitcnt lgkmcnt(0)
    s_barrier
    v_lshlrev_b32 v25, 4, v0
    s_mul_i32 s57, s55, 4608
    v_cmp_gt_u32 vcc, 288, v0
    s_nop 0
    s_and_saveexec_b64 s[58:59], vcc
    s_cbranch_execz L_nostore0
    ds_read_b128 v[124:127], v25 offset:0
    ds_read_b128 v[128:131], v25 offset:8192
    ds_read_b128 v[132:135], v25 offset:16384
    ds_read_b128 v[136:139], v25 offset:24576
    ds_read_b128 v[140:143], v25 offset:32768
    ds_read_b128 v[144:147], v25 offset:40960
    ds_read_b128 v[148:151], v25 offset:49152
    ds_read_b128 v[152:155], v25 offset:57344
    s_waitcnt lgkmcnt(6)
    v_pk_add_f32 v[124:125], v[124:125], v[128:129]
    v_pk_add_f32 v[126:127], v[126:127], v[130:131]
    s_waitcnt lgkmcnt(5)
    v_pk_add_f32 v[124:125], v[124:125], v[132:133]
    v_pk_add_f32 v[126:127], v[126:127], v[134:135]
    s_waitcnt lgkmcnt(4)
    v_pk_add_f32 v[124:125], v[124:125], v[136:137]
    v_pk_add_f32 v[126:127], v[126:127], v[138:139]
    s_waitcnt lgkmcnt(3)
    v_pk_add_f32 v[124:125], v[124:125], v[140:141]
    v_pk_add_f32 v[126:127], v[126:127], v[142:143]
    s_waitcnt lgkmcnt(2)
    v_pk_add_f32 v[124:125], v[124:125], v[144:145]
    v_pk_add_f32 v[126:127], v[126:127], v[146:147]
    s_waitcnt lgkmcnt(1)
    v_pk_add_f32 v[124:125], v[124:125], v[148:149]
    v_pk_add_f32 v[126:127], v[126:127], v[150:151]
    s_waitcnt lgkmcnt(0)
    v_pk_add_f32 v[124:125], v[124:125], v[152:153]
    v_pk_add_f32 v[126:127], v[126:127], v[154:155]
    buffer_store_dwordx4 v[124:127], v25, s[32:35], s57 offen sc1
    s_nop 3
L_nostore0:
    s_mov_b64 exec, -1
    s_add_u32 s57, s57, 8192
    s_waitcnt vmcnt(0)
    s_barrier
    s_cmp_lg_u32 s56, 0
    s_cbranch_scc1 L_end
    s_lshl_b32 s57, s54, 2
    v_mov_b32 v80, s57
    v_mov_b32 v81, 1
    s_mov_b64 exec, 1
    buffer_atomic_add v81, v80, s[40:43], 0 offen sc0
    s_waitcnt vmcnt(0)
    v_readfirstlane_b32 s57, v81
    s_mov_b64 exec, -1
    s_cmp_lg_u32 s57, 3
    s_cbranch_scc1 L_end
    v_lshrrev_b32 v80, 4, v3
    v_and_b32 v81, 15, v3
    v_lshlrev_b32 v82, 4, v81
    v_lshl_add_u32 v82, v80, 9, v82
    v_mov_b32 v83, 0
    s_mov_b32 s68, 0
    s_mov_b32 s72, 4096
    s_mov_b32 s69, 4608
    s_mov_b32 s73, 8704
    s_mov_b32 s70, 9216
    s_mov_b32 s74, 13312
    s_mov_b32 s71, 13824
    s_mov_b32 s75, 17920
    buffer_load_dwordx4 v[100:103], v82, s[32:35], s68 offen offset:0 sc1
    buffer_load_dwordx4 v[104:107], v82, s[32:35], s68 offen offset:256 sc1
    buffer_load_dwordx4 v[108:111], v82, s[32:35], s68 offen offset:2048 sc1
    buffer_load_dwordx4 v[112:115], v82, s[32:35], s68 offen offset:2304 sc1
    buffer_load_dwordx4 v[28:31], v83, s[32:35], s72 offen offset:0 sc1
    buffer_load_dwordx4 v[32:35], v83, s[32:35], s72 offen offset:256 sc1
    buffer_load_dwordx4 v[116:119], v82, s[32:35], s69 offen offset:0 sc1
    buffer_load_dwordx4 v[120:123], v82, s[32:35], s69 offen offset:256 sc1
    buffer_load_dwordx4 v[124:127], v82, s[32:35], s69 offen offset:2048 sc1
    buffer_load_dwordx4 v[128:131], v82, s[32:35], s69 offen offset:2304 sc1
    buffer_load_dwordx4 v[36:39], v83, s[32:35], s73 offen offset:0 sc1
    buffer_load_dwordx4 v[40:43], v83, s[32:35], s73 offen offset:256 sc1
    buffer_load_dwordx4 v[132:135], v82, s[32:35], s70 offen offset:0 sc1
    buffer_load_dwordx4 v[136:139], v82, s[32:35], s70 offen offset:256 sc1
    buffer_load_dwordx4 v[140:143], v82, s[32:35], s70 offen offset:2048 sc1
    buffer_load_dwordx4 v[144:147], v82, s[32:35], s70 offen offset:2304 sc1
    buffer_load_dwordx4 v[44:47], v83, s[32:35], s74 offen offset:0 sc1
    buffer_load_dwordx4 v[48:51], v83, s[32:35], s74 offen offset:256 sc1
    buffer_load_dwordx4 v[148:151], v82, s[32:35], s71 offen offset:0 sc1
    buffer_load_dwordx4 v[152:155], v82, s[32:35], s71 offen offset:256 sc1
    buffer_load_dwordx4 v[156:159], v82, s[32:35], s71 offen offset:2048 sc1
    buffer_load_dwordx4 v[160:163], v82, s[32:35], s71 offen offset:2304 sc1
    buffer_load_dwordx4 v[52:55], v83, s[32:35], s75 offen offset:0 sc1
    buffer_load_dwordx4 v[56:59], v83, s[32:35], s75 offen offset:256 sc1
    s_lshl_b32 s57, s54, 8
    s_add_u32 s36, s12, s57
    s_addc_u32 s37, s13, 0
    s_mov_b32 s38, 256
    s_mov_b32 s39, 0x00020000
    v_lshlrev_b32 v84, 4, v81
    v_lshl_add_u32 v84, v80, 1, v84
    s_waitcnt vmcnt(0)
    v_pk_add_f32 v[100:101], v[100:101], v[116:117]
    v_pk_add_f32 v[102:103], v[102:103], v[118:119]
    v_pk_add_f32 v[104:105], v[104:105], v[120:121]
    v_pk_add_f32 v[106:107], v[106:107], v[122:123]
    v_pk_add_f32 v[108:109], v[108:109], v[124:125]
    v_pk_add_f32 v[110:111], v[110:111], v[126:127]
    v_pk_add_f32 v[112:113], v[112:113], v[128:129]
    v_pk_add_f32 v[114:115], v[114:115], v[130:131]
    v_pk_add_f32 v[28:29], v[28:29], v[36:37]
    v_pk_add_f32 v[30:31], v[30:31], v[38:39]
    v_pk_add_f32 v[32:33], v[32:33], v[40:41]
    v_pk_add_f32 v[34:35], v[34:35], v[42:43]
    v_pk_add_f32 v[100:101], v[100:101], v[132:133]
    v_pk_add_f32 v[102:103], v[102:103], v[134:135]
    v_pk_add_f32 v[104:105], v[104:105], v[136:137]
    v_pk_add_f32 v[106:107], v[106:107], v[138:139]
    v_pk_add_f32 v[108:109], v[108:109], v[140:141]
    v_pk_add_f32 v[110:111], v[110:111], v[142:143]
    v_pk_add_f32 v[112:113], v[112:113], v[144:145]
    v_pk_add_f32 v[114:115], v[114:115], v[146:147]
    v_pk_add_f32 v[28:29], v[28:29], v[44:45]
    v_pk_add_f32 v[30:31], v[30:31], v[46:47]
    v_pk_add_f32 v[32:33], v[32:33], v[48:49]
    v_pk_add_f32 v[34:35], v[34:35], v[50:51]
    v_pk_add_f32 v[100:101], v[100:101], v[148:149]
    v_pk_add_f32 v[102:103], v[102:103], v[150:151]
    v_pk_add_f32 v[104:105], v[104:105], v[152:153]
    v_pk_add_f32 v[106:107], v[106:107], v[154:155]
    v_pk_add_f32 v[108:109], v[108:109], v[156:157]
    v_pk_add_f32 v[110:111], v[110:111], v[158:159]
    v_pk_add_f32 v[112:113], v[112:113], v[160:161]
    v_pk_add_f32 v[114:115], v[114:115], v[162:163]
    v_pk_add_f32 v[28:29], v[28:29], v[52:53]
    v_pk_add_f32 v[30:31], v[30:31], v[54:55]
    v_pk_add_f32 v[32:33], v[32:33], v[56:57]
    v_pk_add_f32 v[34:35], v[34:35], v[58:59]
    v_cvt_pk_bf16_f32 v116, v100, v101
    v_cvt_pk_bf16_f32 v117, v102, v103
    v_cvt_pk_bf16_f32 v118, v104, v105
    v_cvt_pk_bf16_f32 v119, v106, v107
    v_cvt_pk_bf16_f32 v120, v108, v109
    v_cvt_pk_bf16_f32 v121, v110, v111
    v_cvt_pk_bf16_f32 v122, v112, v113
    v_cvt_pk_bf16_f32 v123, v114, v115
    v_cvt_pk_bf16_f32 v124, v28, v29
    v_cvt_pk_bf16_f32 v125, v30, v31
    v_cvt_pk_bf16_f32 v126, v32, v33
    v_cvt_pk_bf16_f32 v127, v34, v35
    v_dot2_f32_bf16 v64, v116, s60, 0
    v_dot2_f32_bf16 v65, v120, s60, 0
    v_dot2_f32_bf16 v66, v124, s60, 0
    v_dot2_f32_bf16 v64, v117, s62, v64
    v_dot2_f32_bf16 v65, v121, s62, v65
    v_dot2_f32_bf16 v66, v125, s62, v66
    v_dot2_f32_bf16 v64, v118, s64, v64
    v_dot2_f32_bf16 v65, v122, s64, v65
    v_dot2_f32_bf16 v66, v126, s64, v66
    v_dot2_f32_bf16 v64, v119, s66, v64
    v_dot2_f32_bf16 v65, v123, s66, v65
    v_dot2_f32_bf16 v66, v127, s66, v66
    v_mov_b32 v67, 0
    s_nop 0
    v_cvt_pk_bf16_f32 v88, v64, v65
    v_cvt_pk_bf16_f32 v89, v66, v67
    v_lshlrev_b32 v64, 16, v88
    v_and_b32 v65, 0xffff0000, v88
    v_lshlrev_b32 v66, 16, v89
    v_and_b32 v67, 0xffff0000, v89
    v_add_f32 v66, s50, v66
    v_cvt_pk_bf16_f32 v88, v66, v66
    v_lshlrev_b32 v66, 16, v88
    v_rcp_f32 v67, v66
    s_nop 0
    v_mul_f32 v88, v64, v67
    v_mul_f32 v89, v65, v67
    v_fma_f32 v90, -v88, v66, v64
    v_fma_f32 v91, -v89, v66, v65
    v_fma_f32 v88, v90, v67, v88
    v_fma_f32 v89, v91, v67, v89
    v_cvt_pk_bf16_f32 v92, v88, v89
    v_lshrrev_b32 v93, 16, v92
    buffer_store_short v92, v84, s[36:39], 0 offen
    buffer_store_short v93, v84, s[36:39], 0 offen offset:8
    s_nop 2
L_end:
    s_endpgm
.section .rodata,"a"
.p2align 6
.amdhsa_kernel standalone__linear_kernel_rfa__decode_kernel
  .amdhsa_next_free_vgpr 208
  .amdhsa_next_free_sgpr 96
  .amdhsa_accum_offset 208
  .amdhsa_group_segment_fixed_size 0
  .amdhsa_kernarg_size 56
  .amdhsa_user_sgpr_count 2
  .amdhsa_user_sgpr_kernarg_segment_ptr 1
  .amdhsa_system_sgpr_workgroup_id_x 1
  .amdhsa_float_denorm_mode_32 3
.end_amdhsa_kernel
```
